```python
import torch

def _softmax(x, axis=-1):
    return torch.softmax(x, dim=axis)
def _gelu(x):
    return torch.nn.functional.gelu(x, approximate="tanh")
def _silu(x):
    return torch.nn.functional.silu(x)
def _sigmoid(x):
    return torch.sigmoid(x)
def _layernorm(x, axis=-1, eps=1e-5):
    m = x.mean(dim=axis, keepdim=True)
    v = x.var(dim=axis, keepdim=True, unbiased=False)
    return (x - m) / torch.sqrt(v + eps)
def _scatter_add(tgt, idx, src, axis=0):
    return tgt.clone().index_add_(axis, idx, src)
def _segment_sum(src, seg, n):
    out = torch.zeros((n,) + src.shape[1:], dtype=src.dtype)
    return out.index_add_(0, seg, src)
def _pad(x, pw):
    flat = tuple(v for pair in reversed(pw) for v in pair)
    return torch.nn.functional.pad(x, flat)

kernel_name = 'gated_mix__sliding_block_cached__geglu_ffn__decode'

def setup_inputs():

    _w = (lambda a: (lambda t: t.to(torch.bfloat16) if t.is_floating_point() else t)(torch.as_tensor(a)))
    def _A_setup():
        B, Sq, D = 1, 1, 640
        Hq, Hkv, Sk, Dh = 32, 32, 32768, 192
        assert Hq % Hkv == 0, (Hq, Hkv)
        return {
            "x": _w((lambda *s: torch.randn(*s, dtype=torch.bfloat16) * 0.05)(B, Sq, D)),
            "k_cache": _w((lambda *s: torch.randn(*s, dtype=torch.bfloat16) * 6.4)(B, Hkv, Sk, Dh)),
            "v_cache": _w((lambda *s: torch.randn(*s, dtype=torch.bfloat16) * 0.2)(B, Hkv, Sk, Dh)),
            "wq": _w((lambda *s: torch.randn(*s, dtype=torch.bfloat16) * 6.4)(D, Hq * Dh) * (D ** -0.5)),
            "wo": _w((lambda *s: torch.randn(*s, dtype=torch.bfloat16) * 0.2)(Hq * Dh, D) * ((Hq * Dh) ** -0.5)),
        }
    _A_in = _A_setup()

    def _B_setup():
        B, S, D, F = 1, 1, 640, 1536
        return {
            "x": _w((lambda *s: torch.randn(*s, dtype=torch.bfloat16) * 0.05)(B, S, D)),
            "w_gate": _w((lambda *s: torch.randn(*s, dtype=torch.bfloat16) * 0.05)(D, F)),
            "w_up": _w((lambda *s: torch.randn(*s, dtype=torch.bfloat16) * 0.05)(D, F)),
            "w_down": _w((lambda *s: torch.randn(*s, dtype=torch.bfloat16) * 0.05)(F, D)),
        }
    _B_in = _B_setup()

    return {
        "A_x": _A_in["x"],
        "A_k_cache": _A_in["k_cache"],
        "A_v_cache": _A_in["v_cache"],
        "A_wq": _A_in["wq"],
        "A_wo": _A_in["wo"],
        "B_x": _B_in["x"],
        "B_w_gate": _B_in["w_gate"],
        "B_w_up": _B_in["w_up"],
        "B_w_down": _B_in["w_down"],
        "gate_w": _w((lambda *s: torch.randn(*s, dtype=torch.bfloat16) * 0.1)(640) * 16.0),
    }

def reference(A_x, A_k_cache, A_v_cache, A_wq, A_wo, B_x, B_w_gate, B_w_up, B_w_down, gate_w):
    def _A_ref(x, k_cache, v_cache, wq, wo):
        B, Sq, D = x.shape
        Hq, Dh = 32, 192
        Hkv, Sk = k_cache.shape[1], k_cache.shape[2]
        W = min(4096, max(256, Sk // 4))
        rep = Hq // Hkv
        q = (lambda x, *d: x.permute(*d))((x @ wq).reshape(B, Sq, Hq, Dh), 0, 2, 1, 3)
        k = (lambda x, n, axis: torch.repeat_interleave(x, n, dim=axis))(k_cache[:, :, Sk - W:, :], rep, axis=1)
        v = (lambda x, n, axis: torch.repeat_interleave(x, n, dim=axis))(v_cache[:, :, Sk - W:, :], rep, axis=1)
        scores = torch.einsum("bhqd,bhkd->bhqk", q, k) * (Dh ** -0.5)
        p = _softmax(scores, axis=-1)
        o = torch.einsum("bhqk,bhkd->bhqd", p, v)
        return (lambda x, *d: x.permute(*d))(o, 0, 2, 1, 3).reshape(B, Sq, Hq * Dh) @ wo

    def _B_ref(x, w_gate, w_up, w_down):
        return (_gelu(x @ w_gate) * (x @ w_up)) @ w_down

    x = A_x
    g = _sigmoid((x * gate_w).sum(-1, keepdims=True))
    a = _A_ref(x, A_k_cache, A_v_cache, A_wq, A_wo)
    b = _B_ref(x, B_w_gate, B_w_up, B_w_down)
    return g * a + (1 - g) * b
```

```asm
; @launch grid=(256,1,1) block=(768,1,1) lds=34816
.amdgcn_target "amdgcn-amd-amdhsa--gfx950"
.text
.globl gated_mix__sliding_block_cached__geglu_ffn__decode_kernel
.p2align 8
.type gated_mix__sliding_block_cached__geglu_ffn__decode_kernel,@function
gated_mix__sliding_block_cached__geglu_ffn__decode_kernel:
    s_cmp_ge_u32 s2, 256
    s_cbranch_scc1 L_end
    s_load_dwordx16 s[4:19], s[0:1], 0
    s_load_dwordx8 s[20:27], s[0:1], 64
    s_load_dwordx2 s[28:29], s[0:1], 96
    v_lshrrev_b32 v52, 6, v0
    v_and_b32 v1, 63, v0
    v_readfirstlane_b32 s32, v52
    v_lshrrev_b32 v2, 3, v1
    v_and_b32 v3, 7, v1
    v_mov_b32 v60, 0
    s_lshr_b32 s30, s2, 3
    s_and_b32 s31, s2, 7
    s_lshr_b32 s3, s2, 2
    s_and_b32 s3, s3, 31
    s_lshr_b32 s60, s2, 7
    s_lshl_b32 s60, s60, 2
    s_and_b32 s36, s2, 3
    s_add_u32 s60, s60, s36
    s_cmp_lt_u32 s32, 4
    s_cbranch_scc0 L_stream
    ds_write2_b32 v60, v60, v60 offset0:98 offset1:99
    ds_write2_b32 v60, v60, v60 offset0:100 offset1:101
    s_mul_i32 s58, s30, 9
    s_lshl_b32 s36, s32, 1
    s_add_u32 s59, s58, s36
    s_mul_i32 s54, s31, 1536
    s_and_b32 s55, s31, 3
    s_mul_i32 s55, s55, 768
    s_sub_u32 s55, s55, 1536
    v_mul_u32_u24 v57, 5, v2
    v_mul_u32_u24 v58, 10, v2
    v_and_b32 v58, -4, v58
    v_lshlrev_b32 v59, 4, v3
    s_waitcnt lgkmcnt(0)
    s_cmp_lt_u32 s31, 4
    s_cselect_b32 s16, s16, s18
    s_cselect_b32 s17, s17, s19
    s_add_u32 s36, s59, 0
    s_lshr_b32 s37, s36, 4
    s_and_b32 s36, s36, 15
    s_cmp_lt_u32 s37, 12
    s_cselect_b32 s40, s10, s16
    s_cselect_b32 s41, s11, s17
    s_cselect_b32 s39, s54, s55
    s_movk_i32 s38, 3072
    s_cselect_b32 s38, 12288, s38
    s_lshl_b32 s37, s37, 7
    s_add_u32 s39, s39, s37
    s_add_u32 s40, s40, s39
    s_addc_u32 s41, s41, 0
    s_mul_i32 s37, s36, 80
    v_add_u32 v52, s37, v58
    global_load_dwordx3 v[20:22], v52, s[4:5]
    s_mul_i32 s37, s36, 40
    v_add_u32 v52, s37, v57
    v_mul_u32_u24 v52, s38, v52
    v_add_u32 v52, v52, v59
    global_load_dwordx4 v[64:67], v52, s[40:41] nt
    v_add_u32 v52, s38, v52
    global_load_dwordx4 v[68:71], v52, s[40:41] nt
    v_add_u32 v52, s38, v52
    global_load_dwordx4 v[72:75], v52, s[40:41] nt
    v_add_u32 v52, s38, v52
    global_load_dwordx4 v[76:79], v52, s[40:41] nt
    v_add_u32 v52, s38, v52
    global_load_dwordx4 v[80:83], v52, s[40:41] nt
    s_add_u32 s36, s59, 1
    s_lshr_b32 s37, s36, 4
    s_and_b32 s36, s36, 15
    s_cmp_lt_u32 s37, 12
    s_cselect_b32 s40, s10, s16
    s_cselect_b32 s41, s11, s17
    s_cselect_b32 s39, s54, s55
    s_movk_i32 s38, 3072
    s_cselect_b32 s38, 12288, s38
    s_lshl_b32 s37, s37, 7
    s_add_u32 s39, s39, s37
    s_add_u32 s40, s40, s39
    s_addc_u32 s41, s41, 0
    s_mul_i32 s37, s36, 80
    v_add_u32 v52, s37, v58
    global_load_dwordx3 v[24:26], v52, s[4:5]
    s_mul_i32 s37, s36, 40
    v_add_u32 v52, s37, v57
    v_mul_u32_u24 v52, s38, v52
    v_add_u32 v52, v52, v59
    global_load_dwordx4 v[84:87], v52, s[40:41] nt
    v_add_u32 v52, s38, v52
    global_load_dwordx4 v[88:91], v52, s[40:41] nt
    v_add_u32 v52, s38, v52
    global_load_dwordx4 v[92:95], v52, s[40:41] nt
    v_add_u32 v52, s38, v52
    global_load_dwordx4 v[96:99], v52, s[40:41] nt
    v_add_u32 v52, s38, v52
    global_load_dwordx4 v[100:103], v52, s[40:41] nt
    s_load_dword s33, s[28:29], 0
    s_barrier
    s_cmp_lt_u32 s32, 3
    s_cbranch_scc1 L_service
    s_add_u32 s36, s59, 2
    s_lshr_b32 s37, s36, 4
    s_and_b32 s36, s36, 15
    s_cmp_lt_u32 s37, 12
    s_cselect_b32 s40, s10, s16
    s_cselect_b32 s41, s11, s17
    s_cselect_b32 s39, s54, s55
    s_movk_i32 s38, 3072
    s_cselect_b32 s38, 12288, s38
    s_lshl_b32 s37, s37, 7
    s_add_u32 s39, s39, s37
    s_add_u32 s40, s40, s39
    s_addc_u32 s41, s41, 0
    s_mul_i32 s37, s36, 80
    v_add_u32 v52, s37, v58
    global_load_dwordx3 v[28:30], v52, s[4:5]
    s_mul_i32 s37, s36, 40
    v_add_u32 v52, s37, v57
    v_mul_u32_u24 v52, s38, v52
    v_add_u32 v52, v52, v59
    global_load_dwordx4 v[104:107], v52, s[40:41] nt
    v_add_u32 v52, s38, v52
    global_load_dwordx4 v[108:111], v52, s[40:41] nt
    v_add_u32 v52, s38, v52
    global_load_dwordx4 v[112:115], v52, s[40:41] nt
    v_add_u32 v52, s38, v52
    global_load_dwordx4 v[116:119], v52, s[40:41] nt
    v_add_u32 v52, s38, v52
    global_load_dwordx4 v[120:123], v52, s[40:41] nt
    s_branch L_service
L_stream:
    s_sub_u32 s32, s32, 4
    v_mul_u32_u24 v10, 384, v2
    v_lshl_add_u32 v10, v3, 4, v10
    s_lshl_b32 s36, s60, 3
    s_add_u32 s36, s36, s32
    s_mul_i32 s61, s3, 37
    s_add_u32 s62, s61, s36
    s_mul_i32 s35, s3, 12582912
    s_add_u32 s35, s35, 11010048
    s_add_u32 s36, s62, 0
    s_and_b32 s36, s36, 511
    s_mul_i32 s36, s36, 3072
    v_add_u32 v9, s36, v10
    s_waitcnt lgkmcnt(0)
    s_add_u32 s6, s6, s35
    s_addc_u32 s7, s7, 0
    global_load_dwordx4 v[64:67], v9, s[6:7] offset:0 nt
    global_load_dwordx4 v[68:71], v9, s[6:7] offset:128 nt
    global_load_dwordx4 v[72:75], v9, s[6:7] offset:256 nt
    s_add_u32 s8, s8, s35
    s_addc_u32 s9, s9, 0
    s_load_dword s33, s[28:29], 0
    s_barrier
    s_mul_i32 s51, s30, 205
    s_lshr_b32 s51, s51, 11
    s_mul_i32 s52, s51, 10
    s_sub_u32 s52, s30, s52
    s_mul_i32 s36, s31, 3
    s_add_u32 s51, s51, s36
    s_min_u32 s51, s51, 23
    v_and_b32 v52, 1, v1
    v_mov_b32 v53, 0xffff
    v_lshlrev_b32 v52, 4, v52
    v_lshlrev_b32 v53, v52, v53
    v_lshrrev_b32 v52, 1, v3
    v_cmp_eq_u32 vcc, 0, v52
    s_nop 1
    v_cndmask_b32 v4, 0, v53, vcc
    v_cmp_eq_u32 vcc, 1, v52
    s_nop 1
    v_cndmask_b32 v5, 0, v53, vcc
    v_cmp_eq_u32 vcc, 2, v52
    s_nop 1
    v_cndmask_b32 v6, 0, v53, vcc
    v_cmp_eq_u32 vcc, 3, v52
    s_nop 1
    v_cndmask_b32 v7, 0, v53, vcc
    v_mov_b32 v8, 0xff
    v_mov_b32 v61, 1
    s_mov_b32 s46, 200000
    v_lshlrev_b32 v160, 4, v1
    v_lshlrev_b32 v164, 2, v2
    s_mov_b32 s49, 0x3d93cd3a
    s_mov_b32 s50, 0x3fb8aa3b
    s_mul_i32 s36, s32, 3968
    v_add_u32 v161, s36, v160
    v_lshrrev_b32 v52, 4, v1
    v_lshl_add_u32 v161, v52, 6, v161
    s_add_u32 s36, s36, 4352
    v_lshlrev_b32 v52, 2, v52
    v_lshl_add_u32 v52, v3, 4, v52
    v_add_u32 v162, s36, v52
    v_lshl_add_u32 v163, v2, 4, s36
    s_lshl_b32 s53, s51, 3
    s_add_u32 s53, s53, s32
    s_lshl_b32 s37, s52, 7
    s_mul_i32 s36, s53, 40960
    s_add_u32 s36, s36, s37
    s_add_u32 s12, s12, s36
    s_addc_u32 s13, s13, 0
    s_mul_i32 s36, s53, 10240
    s_add_u32 s36, s36, s37
    s_add_u32 s20, s20, s36
    s_addc_u32 s21, s21, 0
    v_mov_b32 v32, 0
    v_mov_b32 v33, 0
    v_mov_b32 v34, 0
    v_mov_b32 v35, 0
    v_mov_b32 v36, 0
    v_mov_b32 v37, 0
    v_mov_b32 v38, 0
    v_mov_b32 v39, 0
    v_mov_b32 v40, 0
    v_mov_b32 v41, 0
    v_mov_b32 v42, 0
    v_mov_b32 v43, 0
    v_mov_b32 v44, 0
    v_mov_b32 v45, 0
    v_mov_b32 v46, 0
    v_mov_b32 v47, 0
    v_mov_b32 v48, 0
    v_mov_b32 v49, 0
    v_mov_b32 v50, 0
    v_mov_b32 v51, 0
    s_mul_i32 s36, s30, 9
    s_lshr_b32 s37, s36, 4
    s_and_b32 s36, s36, 15
    s_sub_u32 s38, 16, s36
    s_min_u32 s38, s38, 9
    s_lshr_b32 s39, s10, 7
    s_mul_i32 s36, s31, 12
    s_add_u32 s39, s39, s36
    s_cmp_lt_u32 s31, 4
    s_cselect_b32 s40, s16, s18
    s_lshr_b32 s40, s40, 7
    s_and_b32 s36, s31, 3
    s_mul_i32 s36, s36, 6
    s_add_u32 s40, s40, s36
    s_sub_u32 s40, s40, 12
    s_mov_b32 s63, 0
    s_cmp_lt_u32 s37, 12
    s_cselect_b32 s36, s39, s40
    s_add_u32 s36, s36, s37
    s_and_b32 s36, s36, 7
    s_cmp_eq_u32 s36, 3
    s_cselect_b32 s36, s38, 0
    s_add_u32 s63, s63, s36
    s_add_u32 s37, s37, 1
    s_sub_u32 s38, 9, s38
    s_cmp_lt_u32 s37, 12
    s_cselect_b32 s36, s39, s40
    s_add_u32 s36, s36, s37
    s_and_b32 s36, s36, 7
    s_cmp_eq_u32 s36, 3
    s_cselect_b32 s36, s38, 0
    s_add_u32 s63, s63, s36
    s_mul_i32 s63, s63, 3
    s_lshr_b32 s63, s63, 1
    s_cmp_gt_u32 s63, 0
    s_cbranch_scc1 L_bo3
    s_waitcnt vmcnt(2)
L_bo3:
    s_add_u32 s36, s62, 64
    s_and_b32 s36, s36, 511
    s_mul_i32 s36, s36, 3072
    v_add_u32 v9, s36, v10
    global_load_dwordx4 v[76:79], v9, s[6:7] offset:0 nt
    s_cmp_gt_u32 s63, 1
    s_cbranch_scc1 L_bo4
    s_waitcnt vmcnt(2)
L_bo4:
    global_load_dwordx4 v[80:83], v9, s[6:7] offset:128 nt
    s_waitcnt vmcnt(4)
    s_cmp_gt_u32 s63, 2
    s_cbranch_scc1 L_bo5
    s_waitcnt vmcnt(2)
L_bo5:
    global_load_dwordx4 v[84:87], v9, s[6:7] offset:256 nt
    s_waitcnt vmcnt(4)
    s_cmp_gt_u32 s63, 3
    s_cbranch_scc1 L_bo6
    s_waitcnt vmcnt(2)
L_bo6:
    s_add_u32 s36, s62, 128
    s_and_b32 s36, s36, 511
    s_mul_i32 s36, s36, 3072
    v_add_u32 v9, s36, v10
    global_load_dwordx4 v[88:91], v9, s[6:7] offset:0 nt
    s_waitcnt vmcnt(4)
    s_cmp_gt_u32 s63, 4
    s_cbranch_scc1 L_bo7
    s_waitcnt vmcnt(2)
L_bo7:
    global_load_dwordx4 v[92:95], v9, s[6:7] offset:128 nt
    s_waitcnt vmcnt(4)
    s_cmp_gt_u32 s63, 5
    s_cbranch_scc1 L_bo8
    s_waitcnt vmcnt(2)
L_bo8:
    global_load_dwordx4 v[96:99], v9, s[6:7] offset:256 nt
    s_waitcnt vmcnt(4)
    s_cmp_gt_u32 s63, 6
    s_cbranch_scc1 L_bo9
    s_waitcnt vmcnt(2)
L_bo9:
    s_add_u32 s36, s62, 192
    s_and_b32 s36, s36, 511
    s_mul_i32 s36, s36, 3072
    v_add_u32 v9, s36, v10
    global_load_dwordx4 v[100:103], v9, s[6:7] offset:0 nt
    s_waitcnt vmcnt(4)
    s_cmp_gt_u32 s63, 7
    s_cbranch_scc1 L_bo10
    s_waitcnt vmcnt(2)
L_bo10:
    global_load_dwordx4 v[104:107], v9, s[6:7] offset:128 nt
    s_waitcnt vmcnt(4)
    s_cmp_gt_u32 s63, 8
    s_cbranch_scc1 L_bo11
    s_waitcnt vmcnt(2)
L_bo11:
    global_load_dwordx4 v[108:111], v9, s[6:7] offset:256 nt
    s_waitcnt vmcnt(4)
    s_cmp_gt_u32 s63, 9
    s_cbranch_scc1 L_bo12
    s_waitcnt vmcnt(2)
L_bo12:
    s_add_u32 s36, s62, 256
    s_and_b32 s36, s36, 511
    s_mul_i32 s36, s36, 3072
    v_add_u32 v9, s36, v10
    global_load_dwordx4 v[112:115], v9, s[6:7] offset:0 nt
    s_waitcnt vmcnt(4)
    s_cmp_gt_u32 s63, 10
    s_cbranch_scc1 L_bo13
    s_waitcnt vmcnt(2)
L_bo13:
    global_load_dwordx4 v[116:119], v9, s[6:7] offset:128 nt
    s_waitcnt vmcnt(4)
    s_cmp_gt_u32 s63, 11
    s_cbranch_scc1 L_bo14
    s_waitcnt vmcnt(2)
L_bo14:
    global_load_dwordx4 v[120:123], v9, s[6:7] offset:256 nt
    s_waitcnt vmcnt(4)
    s_cmp_gt_u32 s63, 12
    s_cbranch_scc1 L_bo15
    s_waitcnt vmcnt(2)
L_bo15:
    s_add_u32 s36, s62, 320
    s_and_b32 s36, s36, 511
    s_mul_i32 s36, s36, 3072
    v_add_u32 v9, s36, v10
    global_load_dwordx4 v[124:127], v9, s[6:7] offset:0 nt
    s_waitcnt vmcnt(2)
    global_load_dwordx4 v[128:131], v9, s[6:7] offset:128 nt
    s_waitcnt vmcnt(2)
    global_load_dwordx4 v[132:135], v9, s[6:7] offset:256 nt
    s_waitcnt vmcnt(2)
    s_add_u32 s36, s62, 384
    s_and_b32 s36, s36, 511
    s_mul_i32 s36, s36, 3072
    v_add_u32 v9, s36, v10
    global_load_dwordx4 v[136:139], v9, s[6:7] offset:0 nt
    s_waitcnt vmcnt(2)
    global_load_dwordx4 v[140:143], v9, s[6:7] offset:128 nt
    s_waitcnt vmcnt(2)
    global_load_dwordx4 v[144:147], v9, s[6:7] offset:256 nt
    s_waitcnt vmcnt(2)
    s_add_u32 s36, s62, 448
    s_and_b32 s36, s36, 511
    s_mul_i32 s36, s36, 3072
    v_add_u32 v9, s36, v10
    global_load_dwordx4 v[148:151], v9, s[6:7] offset:0 nt
    s_waitcnt vmcnt(2)
    global_load_dwordx4 v[152:155], v9, s[6:7] offset:128 nt
    v_lshlrev_b32 v52, 4, v3
L_qwait:
    ds_read_b32 v54, v60 offset:392
    ds_read_b128 v[20:23], v52 offset:0
    ds_read_b128 v[24:27], v52 offset:128
    ds_read_b128 v[28:31], v52 offset:256
    s_waitcnt lgkmcnt(0)
    v_cmp_eq_u32 vcc, 0, v54
    s_cmp_eq_u64 vcc, 0
    s_cbranch_scc1 L_qready
    s_sleep 2
    s_branch L_qwait
L_qready:
    s_add_u32 s33, s33, 1
    s_and_b32 s34, s33, 0xff
    s_waitcnt vmcnt(11)
    v_dot2c_f32_bf16 v32, v64, v20
    v_dot2c_f32_bf16 v33, v76, v20
    v_dot2c_f32_bf16 v34, v88, v20
    v_dot2c_f32_bf16 v35, v100, v20
    v_dot2c_f32_bf16 v32, v65, v21
    v_dot2c_f32_bf16 v33, v77, v21
    v_dot2c_f32_bf16 v34, v89, v21
    v_dot2c_f32_bf16 v35, v101, v21
    v_dot2c_f32_bf16 v32, v66, v22
    v_dot2c_f32_bf16 v33, v78, v22
    v_dot2c_f32_bf16 v34, v90, v22
    v_dot2c_f32_bf16 v35, v102, v22
    v_dot2c_f32_bf16 v32, v67, v23
    v_dot2c_f32_bf16 v33, v79, v23
    v_dot2c_f32_bf16 v34, v91, v23
    v_dot2c_f32_bf16 v35, v103, v23
    v_dot2c_f32_bf16 v32, v68, v24
    v_dot2c_f32_bf16 v33, v80, v24
    v_dot2c_f32_bf16 v34, v92, v24
    v_dot2c_f32_bf16 v35, v104, v24
    v_dot2c_f32_bf16 v32, v69, v25
    v_dot2c_f32_bf16 v33, v81, v25
    v_dot2c_f32_bf16 v34, v93, v25
    v_dot2c_f32_bf16 v35, v105, v25
    s_waitcnt vmcnt(2)
    global_load_dwordx4 v[156:159], v9, s[6:7] offset:256 nt
    v_dot2c_f32_bf16 v32, v70, v26
    v_dot2c_f32_bf16 v33, v82, v26
    v_dot2c_f32_bf16 v34, v94, v26
    v_dot2c_f32_bf16 v35, v106, v26
    v_dot2c_f32_bf16 v32, v71, v27
    v_dot2c_f32_bf16 v33, v83, v27
    v_dot2c_f32_bf16 v34, v95, v27
    v_dot2c_f32_bf16 v35, v107, v27
    v_dot2c_f32_bf16 v32, v72, v28
    v_dot2c_f32_bf16 v33, v84, v28
    v_dot2c_f32_bf16 v34, v96, v28
    v_dot2c_f32_bf16 v35, v108, v28
    v_dot2c_f32_bf16 v32, v73, v29
    v_dot2c_f32_bf16 v33, v85, v29
    v_dot2c_f32_bf16 v34, v97, v29
    v_dot2c_f32_bf16 v35, v109, v29
    v_dot2c_f32_bf16 v32, v74, v30
    v_dot2c_f32_bf16 v33, v86, v30
    v_dot2c_f32_bf16 v34, v98, v30
    v_dot2c_f32_bf16 v35, v110, v30
    v_dot2c_f32_bf16 v32, v75, v31
    v_dot2c_f32_bf16 v33, v87, v31
    v_dot2c_f32_bf16 v34, v99, v31
    v_dot2c_f32_bf16 v35, v111, v31
    s_waitcnt vmcnt(2)
    s_add_u32 s36, s62, 0
    s_and_b32 s36, s36, 511
    s_mul_i32 s36, s36, 3072
    v_add_u32 v9, s36, v10
    global_load_dwordx4 v[64:67], v9, s[8:9] offset:0 nt
    s_waitcnt vmcnt(2)
    global_load_dwordx4 v[68:71], v9, s[8:9] offset:128 nt
    s_waitcnt vmcnt(2)
    global_load_dwordx4 v[72:75], v9, s[8:9] offset:256 nt
    v_dot2c_f32_bf16 v36, v112, v20
    v_dot2c_f32_bf16 v37, v124, v20
    v_dot2c_f32_bf16 v38, v136, v20
    v_dot2c_f32_bf16 v39, v148, v20
    v_dot2c_f32_bf16 v36, v113, v21
    v_dot2c_f32_bf16 v37, v125, v21
    v_dot2c_f32_bf16 v38, v137, v21
    v_dot2c_f32_bf16 v39, v149, v21
    v_dot2c_f32_bf16 v36, v114, v22
    v_dot2c_f32_bf16 v37, v126, v22
    v_dot2c_f32_bf16 v38, v138, v22
    v_dot2c_f32_bf16 v39, v150, v22
    v_dot2c_f32_bf16 v36, v115, v23
    v_dot2c_f32_bf16 v37, v127, v23
    v_dot2c_f32_bf16 v38, v139, v23
    v_dot2c_f32_bf16 v39, v151, v23
    v_dot2c_f32_bf16 v36, v116, v24
    v_dot2c_f32_bf16 v37, v128, v24
    v_dot2c_f32_bf16 v38, v140, v24
    v_dot2c_f32_bf16 v39, v152, v24
    v_dot2c_f32_bf16 v36, v117, v25
    v_dot2c_f32_bf16 v37, v129, v25
    v_dot2c_f32_bf16 v38, v141, v25
    v_dot2c_f32_bf16 v39, v153, v25
    s_waitcnt vmcnt(2)
    s_add_u32 s36, s62, 64
    s_and_b32 s36, s36, 511
    s_mul_i32 s36, s36, 3072
    v_add_u32 v9, s36, v10
    global_load_dwordx4 v[76:79], v9, s[8:9] offset:0 nt
    v_dot2c_f32_bf16 v36, v118, v26
    v_dot2c_f32_bf16 v37, v130, v26
    v_dot2c_f32_bf16 v38, v142, v26
    v_dot2c_f32_bf16 v39, v154, v26
    v_dot2c_f32_bf16 v36, v119, v27
    v_dot2c_f32_bf16 v37, v131, v27
    v_dot2c_f32_bf16 v38, v143, v27
    v_dot2c_f32_bf16 v39, v155, v27
    v_dot2c_f32_bf16 v36, v120, v28
    v_dot2c_f32_bf16 v37, v132, v28
    v_dot2c_f32_bf16 v38, v144, v28
    v_dot2c_f32_bf16 v39, v156, v28
    v_dot2c_f32_bf16 v36, v121, v29
    v_dot2c_f32_bf16 v37, v133, v29
    v_dot2c_f32_bf16 v38, v145, v29
    v_dot2c_f32_bf16 v39, v157, v29
    v_dot2c_f32_bf16 v36, v122, v30
    v_dot2c_f32_bf16 v37, v134, v30
    v_dot2c_f32_bf16 v38, v146, v30
    v_dot2c_f32_bf16 v39, v158, v30
    v_dot2c_f32_bf16 v36, v123, v31
    v_dot2c_f32_bf16 v37, v135, v31
    v_dot2c_f32_bf16 v38, v147, v31
    v_dot2c_f32_bf16 v39, v159, v31
    v_add_f32_dpp v32, v32, v32 quad_perm:[1,0,3,2] row_mask:0xf bank_mask:0xf
    v_add_f32_dpp v33, v33, v33 quad_perm:[1,0,3,2] row_mask:0xf bank_mask:0xf
    v_add_f32_dpp v34, v34, v34 quad_perm:[1,0,3,2] row_mask:0xf bank_mask:0xf
    v_add_f32_dpp v35, v35, v35 quad_perm:[1,0,3,2] row_mask:0xf bank_mask:0xf
    v_add_f32_dpp v36, v36, v36 quad_perm:[1,0,3,2] row_mask:0xf bank_mask:0xf
    v_add_f32_dpp v37, v37, v37 quad_perm:[1,0,3,2] row_mask:0xf bank_mask:0xf
    v_add_f32_dpp v38, v38, v38 quad_perm:[1,0,3,2] row_mask:0xf bank_mask:0xf
    v_add_f32_dpp v39, v39, v39 quad_perm:[1,0,3,2] row_mask:0xf bank_mask:0xf
    v_add_f32_dpp v32, v32, v32 quad_perm:[2,3,0,1] row_mask:0xf bank_mask:0xf
    v_add_f32_dpp v33, v33, v33 quad_perm:[2,3,0,1] row_mask:0xf bank_mask:0xf
    v_add_f32_dpp v34, v34, v34 quad_perm:[2,3,0,1] row_mask:0xf bank_mask:0xf
    v_add_f32_dpp v35, v35, v35 quad_perm:[2,3,0,1] row_mask:0xf bank_mask:0xf
    v_add_f32_dpp v36, v36, v36 quad_perm:[2,3,0,1] row_mask:0xf bank_mask:0xf
    v_add_f32_dpp v37, v37, v37 quad_perm:[2,3,0,1] row_mask:0xf bank_mask:0xf
    v_add_f32_dpp v38, v38, v38 quad_perm:[2,3,0,1] row_mask:0xf bank_mask:0xf
    v_add_f32_dpp v39, v39, v39 quad_perm:[2,3,0,1] row_mask:0xf bank_mask:0xf
    v_add_f32_dpp v32, v32, v32 row_half_mirror row_mask:0xf bank_mask:0xf
    v_add_f32_dpp v33, v33, v33 row_half_mirror row_mask:0xf bank_mask:0xf
    v_add_f32_dpp v34, v34, v34 row_half_mirror row_mask:0xf bank_mask:0xf
    v_add_f32_dpp v35, v35, v35 row_half_mirror row_mask:0xf bank_mask:0xf
    v_add_f32_dpp v36, v36, v36 row_half_mirror row_mask:0xf bank_mask:0xf
    v_add_f32_dpp v37, v37, v37 row_half_mirror row_mask:0xf bank_mask:0xf
    v_add_f32_dpp v38, v38, v38 row_half_mirror row_mask:0xf bank_mask:0xf
    v_add_f32_dpp v39, v39, v39 row_half_mirror row_mask:0xf bank_mask:0xf
    v_cvt_pk_bf16_f32 v52, v32, v33
    v_cvt_pk_bf16_f32 v53, v34, v35
    v_cvt_pk_bf16_f32 v54, v36, v37
    v_cvt_pk_bf16_f32 v55, v38, v39
    v_lshlrev_b32 v32, 16, v52
    v_and_b32 v33, 0xffff0000, v52
    v_lshlrev_b32 v34, 16, v53
    v_and_b32 v35, 0xffff0000, v53
    v_lshlrev_b32 v36, 16, v54
    v_and_b32 v37, 0xffff0000, v54
    v_lshlrev_b32 v38, 16, v55
    v_and_b32 v39, 0xffff0000, v55
    v_mul_f32 v32, s49, v32
    v_mul_f32 v33, s49, v33
    v_mul_f32 v34, s49, v34
    v_mul_f32 v35, s49, v35
    v_mul_f32 v36, s49, v36
    v_mul_f32 v37, s49, v37
    v_mul_f32 v38, s49, v38
    v_mul_f32 v39, s49, v39
    v_cvt_pk_bf16_f32 v52, v32, v33
    v_cvt_pk_bf16_f32 v53, v34, v35
    v_cvt_pk_bf16_f32 v54, v36, v37
    v_cvt_pk_bf16_f32 v55, v38, v39
    v_lshlrev_b32 v32, 16, v52
    v_and_b32 v33, 0xffff0000, v52
    v_lshlrev_b32 v34, 16, v53
    v_and_b32 v35, 0xffff0000, v53
    v_lshlrev_b32 v36, 16, v54
    v_and_b32 v37, 0xffff0000, v54
    v_lshlrev_b32 v38, 16, v55
    v_and_b32 v39, 0xffff0000, v55
    s_waitcnt vmcnt(2)
    global_load_dwordx4 v[80:83], v9, s[8:9] offset:128 nt
    v_max3_f32 v52, v32, v33, v34
    v_max3_f32 v53, v35, v36, v37
    v_max3_f32 v52, v52, v38, v39
    v_max_f32 v52, v52, v53
    s_nop 1
    v_max_f32_dpp v52, v52, v52 row_ror:8 row_mask:0xf bank_mask:0xf
    s_nop 1
    v_max_f32_dpp v52, v52, v52 row_bcast:15 row_mask:0xa bank_mask:0xf
    s_nop 1
    v_max_f32_dpp v52, v52, v52 row_bcast:31 row_mask:0xc bank_mask:0xf
    v_mul_f32 v52, s50, v52
    s_nop 0
    v_readlane_b32 s37, v52, 63
    s_nop 1
    v_mov_b32 v62, s37
    v_fma_f32 v32, v32, s50, -v62
    v_fma_f32 v33, v33, s50, -v62
    v_fma_f32 v34, v34, s50, -v62
    v_fma_f32 v35, v35, s50, -v62
    v_fma_f32 v36, v36, s50, -v62
    v_fma_f32 v37, v37, s50, -v62
    v_fma_f32 v38, v38, s50, -v62
    v_fma_f32 v39, v39, s50, -v62
    v_exp_f32 v32, v32
    v_exp_f32 v33, v33
    v_exp_f32 v34, v34
    v_exp_f32 v35, v35
    v_exp_f32 v36, v36
    v_exp_f32 v37, v37
    v_exp_f32 v38, v38
    v_exp_f32 v39, v39
    v_add_f32 v63, v32, v33
    v_add_f32 v63, v63, v34
    v_add_f32 v63, v63, v35
    v_add_f32 v63, v63, v36
    v_add_f32 v63, v63, v37
    v_add_f32 v63, v63, v38
    v_add_f32 v63, v63, v39
    v_cvt_pk_bf16_f32 v32, v32, v32
    v_cvt_pk_bf16_f32 v33, v33, v33
    v_cvt_pk_bf16_f32 v34, v34, v34
    v_cvt_pk_bf16_f32 v35, v35, v35
    v_cvt_pk_bf16_f32 v36, v36, v36
    v_cvt_pk_bf16_f32 v37, v37, v37
    v_cvt_pk_bf16_f32 v38, v38, v38
    v_cvt_pk_bf16_f32 v39, v39, v39
    s_nop 1
    v_add_f32_dpp v63, v63, v63 row_ror:8 row_mask:0xf bank_mask:0xf
    s_nop 1
    v_add_f32_dpp v63, v63, v63 row_bcast:15 row_mask:0xa bank_mask:0xf
    s_nop 1
    v_add_f32_dpp v63, v63, v63 row_bcast:31 row_mask:0xc bank_mask:0xf
    s_lshl_b32 s36, s32, 2
    v_mov_b32 v52, s36
    s_mov_b32 exec_lo, 0
    s_mov_b32 exec_hi, 0x80000000
    ds_write2_b32 v52, v62, v63 offset0:112 offset1:120
    ds_add_u32 v60, v61 offset:396
    s_mov_b64 exec, -1
    s_waitcnt vmcnt(2)
    global_load_dwordx4 v[84:87], v9, s[8:9] offset:256 nt
    v_mul_u32_u24 v22, 1280, v2
    v_lshl_add_u32 v22, v3, 4, v22
    v_and_b32 v53, 1, v2
    v_lshrrev_b32 v52, 1, v2
    v_lshl_add_u32 v52, v53, 4, v52
    v_add_u32 v52, 2, v52
    v_mul_u32_u24 v20, 1280, v52
    v_lshl_add_u32 v20, v3, 4, v20
    v_add_u32 v21, 10240, v20
    s_lshr_b32 s36, s32, 1
    s_mul_i32 s36, s36, 1280
    s_and_b32 s37, s32, 1
    s_lshl_b32 s37, s37, 6
    s_add_u32 s36, s36, s37
    v_mul_u32_u24 v28, 3968, v2
    v_lshrrev_b32 v52, 1, v3
    v_lshl_add_u32 v28, v52, 4, v28
    v_and_b32 v53, 1, v3
    v_mul_u32_u24 v53, 320, v53
    v_add_u32 v28, v53, v28
    v_add_u32 v28, s36, v28
    v_lshrrev_b32 v52, 4, v1
    v_lshlrev_b32 v52, 5, v52
    v_lshl_add_u32 v52, v3, 2, v52
    s_mul_i32 s36, s3, 6
    s_add_u32 s36, s36, s32
    s_lshl_b32 s36, s36, 10
    s_lshl_b32 s37, s60, 7
    s_add_u32 s36, s36, s37
    s_add_u32 s36, s36, 147456
    v_add_u32 v23, s36, v52
    s_lshl_b32 s36, s52, 1
    s_add_u32 s36, s36, s32
    s_lshl_b32 s36, s36, 12
    s_lshl_b32 s37, s51, 7
    s_add_u32 s36, s36, s37
    s_add_u32 s36, s36, 344064
    v_add_u32 v26, s36, v52
    s_lshl_b32 s36, s53, 10
    s_add_u32 s36, s36, 147456
    v_add_u32 v24, s36, v160
    s_lshl_b32 s36, s32, 5
    v_add_u32 v27, s36, v164
    v_and_b32 v12, v32, v4
    v_and_b32 v13, v32, v5
    v_and_b32 v14, v32, v6
    v_and_b32 v15, v32, v7
    s_waitcnt vmcnt(5)
    s_nop 0
    v_mfma_f32_16x16x32_bf16 v[40:43], v[12:15], v[64:67], v[40:43]
    s_waitcnt vmcnt(4)
    v_mfma_f32_16x16x32_bf16 v[44:47], v[12:15], v[68:71], v[44:47]
    s_waitcnt vmcnt(3)
    v_mfma_f32_16x16x32_bf16 v[48:51], v[12:15], v[72:75], v[48:51]
    v_and_b32 v16, v33, v4
    v_and_b32 v17, v33, v5
    v_and_b32 v18, v33, v6
    v_and_b32 v19, v33, v7
    s_waitcnt vmcnt(2)
    s_add_u32 s36, s62, 128
    s_and_b32 s36, s36, 511
    s_mul_i32 s36, s36, 3072
    v_add_u32 v9, s36, v10
    global_load_dwordx4 v[88:91], v9, s[8:9] offset:0 nt
    v_mfma_f32_16x16x32_bf16 v[40:43], v[16:19], v[76:79], v[40:43]
    s_waitcnt vmcnt(2)
    global_load_dwordx4 v[92:95], v9, s[8:9] offset:128 nt
    v_mfma_f32_16x16x32_bf16 v[44:47], v[16:19], v[80:83], v[44:47]
    s_waitcnt vmcnt(2)
    global_load_dwordx4 v[96:99], v9, s[8:9] offset:256 nt
    v_mfma_f32_16x16x32_bf16 v[48:51], v[16:19], v[84:87], v[48:51]
    v_and_b32 v12, v34, v4
    v_and_b32 v13, v34, v5
    v_and_b32 v14, v34, v6
    v_and_b32 v15, v34, v7
    s_waitcnt vmcnt(2)
    s_add_u32 s36, s62, 192
    s_and_b32 s36, s36, 511
    s_mul_i32 s36, s36, 3072
    v_add_u32 v9, s36, v10
    global_load_dwordx4 v[100:103], v9, s[8:9] offset:0 nt
    v_mfma_f32_16x16x32_bf16 v[40:43], v[12:15], v[88:91], v[40:43]
    s_waitcnt vmcnt(2)
    global_load_dwordx4 v[104:107], v9, s[8:9] offset:128 nt
    v_mfma_f32_16x16x32_bf16 v[44:47], v[12:15], v[92:95], v[44:47]
    s_waitcnt vmcnt(2)
    global_load_dwordx4 v[108:111], v9, s[8:9] offset:256 nt
    v_mfma_f32_16x16x32_bf16 v[48:51], v[12:15], v[96:99], v[48:51]
    v_and_b32 v16, v35, v4
    v_and_b32 v17, v35, v5
    v_and_b32 v18, v35, v6
    v_and_b32 v19, v35, v7
    s_waitcnt vmcnt(2)
    s_add_u32 s36, s62, 256
    s_and_b32 s36, s36, 511
    s_mul_i32 s36, s36, 3072
    v_add_u32 v9, s36, v10
    global_load_dwordx4 v[112:115], v9, s[8:9] offset:0 nt
    v_mfma_f32_16x16x32_bf16 v[40:43], v[16:19], v[100:103], v[40:43]
    s_waitcnt vmcnt(2)
    global_load_dwordx4 v[116:119], v9, s[8:9] offset:128 nt
    v_mfma_f32_16x16x32_bf16 v[44:47], v[16:19], v[104:107], v[44:47]
    s_waitcnt vmcnt(2)
    global_load_dwordx4 v[120:123], v9, s[8:9] offset:256 nt
    v_mfma_f32_16x16x32_bf16 v[48:51], v[16:19], v[108:111], v[48:51]
    v_and_b32 v12, v36, v4
    v_and_b32 v13, v36, v5
    v_and_b32 v14, v36, v6
    v_and_b32 v15, v36, v7
    s_waitcnt vmcnt(2)
    s_add_u32 s36, s62, 320
    s_and_b32 s36, s36, 511
    s_mul_i32 s36, s36, 3072
    v_add_u32 v9, s36, v10
    global_load_dwordx4 v[124:127], v9, s[8:9] offset:0 nt
    v_mfma_f32_16x16x32_bf16 v[40:43], v[12:15], v[112:115], v[40:43]
    s_waitcnt vmcnt(2)
    global_load_dwordx4 v[128:131], v9, s[8:9] offset:128 nt
    v_mfma_f32_16x16x32_bf16 v[44:47], v[12:15], v[116:119], v[44:47]
    s_waitcnt vmcnt(2)
    global_load_dwordx4 v[132:135], v9, s[8:9] offset:256 nt
    v_mfma_f32_16x16x32_bf16 v[48:51], v[12:15], v[120:123], v[48:51]
    v_and_b32 v16, v37, v4
    v_and_b32 v17, v37, v5
    v_and_b32 v18, v37, v6
    v_and_b32 v19, v37, v7
    s_waitcnt vmcnt(2)
    s_add_u32 s36, s62, 384
    s_and_b32 s36, s36, 511
    s_mul_i32 s36, s36, 3072
    v_add_u32 v9, s36, v10
    global_load_dwordx4 v[136:139], v9, s[8:9] offset:0 nt
    v_mfma_f32_16x16x32_bf16 v[40:43], v[16:19], v[124:127], v[40:43]
    s_waitcnt vmcnt(2)
    global_load_dwordx4 v[140:143], v9, s[8:9] offset:128 nt
    v_mfma_f32_16x16x32_bf16 v[44:47], v[16:19], v[128:131], v[44:47]
    s_waitcnt vmcnt(2)
    global_load_dwordx4 v[144:147], v9, s[8:9] offset:256 nt
    v_mfma_f32_16x16x32_bf16 v[48:51], v[16:19], v[132:135], v[48:51]
    v_and_b32 v12, v38, v4
    v_and_b32 v13, v38, v5
    v_and_b32 v14, v38, v6
    v_and_b32 v15, v38, v7
    s_waitcnt vmcnt(2)
    s_add_u32 s36, s62, 448
    s_and_b32 s36, s36, 511
    s_mul_i32 s36, s36, 3072
    v_add_u32 v9, s36, v10
    global_load_dwordx4 v[148:151], v9, s[8:9] offset:0 nt
    v_mfma_f32_16x16x32_bf16 v[40:43], v[12:15], v[136:139], v[40:43]
    s_waitcnt vmcnt(2)
    global_load_dwordx4 v[152:155], v9, s[8:9] offset:128 nt
    v_mfma_f32_16x16x32_bf16 v[44:47], v[12:15], v[140:143], v[44:47]
    s_waitcnt vmcnt(2)
    global_load_dwordx4 v[156:159], v9, s[8:9] offset:256 nt
    v_mfma_f32_16x16x32_bf16 v[48:51], v[12:15], v[144:147], v[48:51]
    s_cmp_lt_u32 s2, 240
    s_cbranch_scc1 L_pvA
    v_and_b32 v16, v39, v4
    v_and_b32 v17, v39, v5
    v_and_b32 v18, v39, v6
    v_and_b32 v19, v39, v7
    s_waitcnt vmcnt(2)
    s_nop 0
    v_mfma_f32_16x16x32_bf16 v[40:43], v[16:19], v[148:151], v[40:43]
    s_waitcnt vmcnt(1)
    v_mfma_f32_16x16x32_bf16 v[44:47], v[16:19], v[152:155], v[44:47]
    s_waitcnt vmcnt(0)
    v_mfma_f32_16x16x32_bf16 v[48:51], v[16:19], v[156:159], v[48:51]
    s_branch L_pvdone
L_pvA:
    v_and_b32 v16, v39, v4
    v_and_b32 v17, v39, v5
    v_and_b32 v18, v39, v6
    v_and_b32 v19, v39, v7
    s_waitcnt vmcnt(2)
    global_load_dwordx4 v[64:67], v22, s[20:21] nt
    v_mfma_f32_16x16x32_bf16 v[40:43], v[16:19], v[148:151], v[40:43]
    s_waitcnt vmcnt(2)
    global_load_dwordx4 v[68:71], v20, s[12:13] offset:-2560 nt
    v_mfma_f32_16x16x32_bf16 v[44:47], v[16:19], v[152:155], v[44:47]
    s_waitcnt vmcnt(2)
    global_load_dwordx4 v[72:75], v20, s[12:13] offset:2560 nt
    v_mfma_f32_16x16x32_bf16 v[48:51], v[16:19], v[156:159], v[48:51]
    global_load_dwordx4 v[76:79], v21, s[12:13] offset:-2560 nt
    global_load_dwordx4 v[80:83], v21, s[12:13] offset:2560 nt
L_pvdone:
    s_nop 5
    ds_write_b128 v161, v[40:43] offset:3072
    ds_write_b128 v161, v[44:47] offset:4352
    ds_write_b128 v161, v[48:51] offset:5632
    s_cmp_lt_u32 s32, 6
    s_waitcnt lgkmcnt(0)
    s_barrier
    s_cbranch_scc0 L_nopub
    ds_read_b128 v[40:43], v28 offset:3072
    ds_read_b128 v[44:47], v28 offset:3840
    ds_read_b32 v50, v164 offset:416
    s_waitcnt lgkmcnt(0)
    v_add_f32 v40, v40, v44
    v_add_f32 v41, v41, v45
    v_add_f32 v42, v42, v46
    v_add_f32 v43, v43, v47
    v_mul_f32 v40, v40, v50
    v_mul_f32 v41, v41, v50
    v_mul_f32 v42, v42, v50
    v_mul_f32 v43, v43, v50
    s_nop 0
    v_permlane32_swap_b32 v40, v42
    v_permlane32_swap_b32 v41, v43
    v_add_f32 v40, v40, v42
    v_add_f32 v41, v41, v43
    s_nop 1
    v_permlane16_swap_b32 v40, v41
    v_add_f32 v40, v40, v41
    s_mov_b32 s36, 0x00ff00ff
    s_mov_b32 s37, 0x00ff00ff
    v_add_f32_dpp v40, v40, v40 row_ror:8 row_mask:0xf bank_mask:0xf
    v_bfi_b32 v40, v8, s34, v40
    s_mov_b64 exec, s[36:37]
    global_store_dword v23, v40, s[28:29] sc1
    s_mov_b64 exec, -1
L_nopub:
    s_cmp_lt_u32 s2, 240
    s_barrier
    s_cbranch_scc0 L_tailB
    global_load_dwordx4 v[32:35], v24, s[28:29] sc1
    ds_read_b32 v27, v27 offset:512
    ds_read_b64 v[30:31], v60 offset:384
    s_waitcnt lgkmcnt(0)
    v_and_b32 v12, v27, v4
    v_and_b32 v13, v27, v5
    v_and_b32 v14, v27, v6
    v_and_b32 v15, v27, v7
    s_waitcnt vmcnt(5)
    s_nop 0
    v_mfma_f32_16x16x32_bf16 v[44:47], v[12:15], v[64:67], 0
    s_nop 7
    v_mul_f32 v56, v31, v44
    v_mul_f32 v57, v31, v45
    v_mul_f32 v58, v31, v46
    v_mul_f32 v59, v31, v47
    s_waitcnt vmcnt(0)
L_o_chk:
    v_xor_b32 v32, s34, v32
    v_xor_b32 v33, s34, v33
    v_xor_b32 v34, s34, v34
    v_xor_b32 v35, s34, v35
    v_or3_b32 v52, v32, v33, v34
    v_or_b32 v52, v52, v35
    v_and_b32 v52, v8, v52
    v_cmp_ne_u32 vcc, 0, v52
    s_cmp_eq_u64 vcc, 0
    s_cbranch_scc1 L_o_ok
    s_sub_u32 s46, s46, 1
    s_cbranch_scc1 L_o_ok
    global_load_dwordx4 v[32:35], v24, s[28:29] sc1
    s_waitcnt vmcnt(0)
    s_branch L_o_chk
L_o_ok:
    v_permlane32_swap_b32 v32, v34
    v_permlane32_swap_b32 v33, v35
    v_add_f32 v32, v32, v34
    v_add_f32 v33, v33, v35
    s_nop 1
    v_permlane16_swap_b32 v32, v33
    v_add_f32 v32, v32, v33
    s_nop 1
    v_add_f32_dpp v32, v32, v32 row_ror:8 row_mask:0xf bank_mask:0xf
    v_cvt_pk_bf16_f32 v32, v32, v32
    ds_write_b32 v162, v32
    ds_read_b128 v[32:35], v163
    s_waitcnt lgkmcnt(0)
    v_and_b32 v12, v32, v4
    v_and_b32 v13, v32, v5
    v_and_b32 v14, v32, v6
    v_and_b32 v15, v32, v7
    v_and_b32 v16, v33, v4
    v_and_b32 v17, v33, v5
    v_and_b32 v18, v33, v6
    v_and_b32 v19, v33, v7
    v_mfma_f32_16x16x32_bf16 v[44:47], v[12:15], v[68:71], 0
    v_and_b32 v36, v34, v4
    v_and_b32 v37, v34, v5
    v_and_b32 v38, v34, v6
    v_and_b32 v39, v34, v7
    v_mfma_f32_16x16x32_bf16 v[44:47], v[16:19], v[72:75], v[44:47]
    v_and_b32 v48, v35, v4
    v_and_b32 v49, v35, v5
    v_and_b32 v50, v35, v6
    v_and_b32 v51, v35, v7
    v_mfma_f32_16x16x32_bf16 v[44:47], v[36:39], v[76:79], v[44:47]
    s_nop 0
    v_mfma_f32_16x16x32_bf16 v[44:47], v[48:51], v[80:83], v[44:47]
    s_nop 7
    v_fma_f32 v44, v44, v30, v56
    v_fma_f32 v45, v45, v30, v57
    v_fma_f32 v46, v46, v30, v58
    v_fma_f32 v47, v47, v30, v59
    ds_write_b128 v161, v[44:47] offset:3072
    s_cmp_lt_u32 s32, 2
    s_waitcnt lgkmcnt(0)
    s_barrier
    s_cbranch_scc0 L_exitS
    ds_read_b128 v[40:43], v28 offset:3072
    ds_read_b128 v[44:47], v28 offset:3840
    s_waitcnt lgkmcnt(0)
    v_add_f32 v40, v40, v44
    v_add_f32 v41, v41, v45
    v_add_f32 v42, v42, v46
    v_add_f32 v43, v43, v47
    s_nop 0
    v_permlane32_swap_b32 v40, v42
    v_permlane32_swap_b32 v41, v43
    v_add_f32 v40, v40, v42
    v_add_f32 v41, v41, v43
    s_nop 1
    v_permlane16_swap_b32 v40, v41
    v_add_f32 v40, v40, v41
    s_mov_b32 s36, 0x00ff00ff
    s_mov_b32 s37, 0x00ff00ff
    v_add_f32_dpp v40, v40, v40 row_ror:8 row_mask:0xf bank_mask:0xf
    v_bfi_b32 v40, v8, s34, v40
    s_mov_b64 exec, s[36:37]
    global_store_dword v26, v40, s[28:29] sc1
    s_branch L_exitS
L_tailB:
    s_sub_u32 s36, s2, 240
    s_lshl_b32 s37, s32, 4
    s_add_u32 s38, s36, s37
    s_cmp_lt_u32 s38, 20
    s_cbranch_scc0 L_exitS
    s_lshl_b32 s36, s38, 12
    s_add_u32 s36, s36, 344064
    v_add_u32 v24, s36, v160
    v_and_b32 v52, 1, v3
    v_lshlrev_b32 v52, 4, v52
    v_lshrrev_b32 v53, 4, v1
    v_lshl_add_u32 v52, v53, 2, v52
    v_lshrrev_b32 v53, 1, v3
    s_lshl_b32 s36, s38, 5
    v_add3_u32 v26, v52, v53, s36
    v_lshlrev_b32 v26, 1, v26
    global_load_dwordx4 v[112:115], v24, s[28:29] offset:0 sc1
    global_load_dwordx4 v[116:119], v24, s[28:29] offset:1024 sc1
    global_load_dwordx4 v[120:123], v24, s[28:29] offset:2048 sc1
    s_sleep 2
    global_load_dwordx4 v[124:127], v24, s[28:29] offset:0 sc1
    global_load_dwordx4 v[128:131], v24, s[28:29] offset:1024 sc1
    global_load_dwordx4 v[132:135], v24, s[28:29] offset:2048 sc1
    s_sleep 2
    global_load_dwordx4 v[136:139], v24, s[28:29] offset:0 sc1
    global_load_dwordx4 v[140:143], v24, s[28:29] offset:1024 sc1
    global_load_dwordx4 v[144:147], v24, s[28:29] offset:2048 sc1
L_f_loop:
    s_waitcnt vmcnt(6)
    v_xor_b32 v32, s34, v112
    v_xor_b32 v33, s34, v113
    v_xor_b32 v34, s34, v114
    v_xor_b32 v35, s34, v115
    v_xor_b32 v36, s34, v116
    v_xor_b32 v37, s34, v117
    v_xor_b32 v38, s34, v118
    v_xor_b32 v39, s34, v119
    v_xor_b32 v40, s34, v120
    v_xor_b32 v41, s34, v121
    v_xor_b32 v42, s34, v122
    v_xor_b32 v43, s34, v123
    v_or3_b32 v52, v32, v33, v34
    v_or3_b32 v52, v52, v35, v36
    v_or3_b32 v52, v52, v37, v38
    v_or3_b32 v52, v52, v39, v40
    v_or3_b32 v52, v52, v41, v42
    v_or_b32 v52, v52, v43
    v_and_b32 v52, v8, v52
    v_cmp_ne_u32 vcc, 0, v52
    s_cmp_eq_u64 vcc, 0
    s_cbranch_scc1 L_f_ok
    global_load_dwordx4 v[112:115], v24, s[28:29] offset:0 sc1
    global_load_dwordx4 v[116:119], v24, s[28:29] offset:1024 sc1
    global_load_dwordx4 v[120:123], v24, s[28:29] offset:2048 sc1
    s_waitcnt vmcnt(6)
    v_xor_b32 v32, s34, v124
    v_xor_b32 v33, s34, v125
    v_xor_b32 v34, s34, v126
    v_xor_b32 v35, s34, v127
    v_xor_b32 v36, s34, v128
    v_xor_b32 v37, s34, v129
    v_xor_b32 v38, s34, v130
    v_xor_b32 v39, s34, v131
    v_xor_b32 v40, s34, v132
    v_xor_b32 v41, s34, v133
    v_xor_b32 v42, s34, v134
    v_xor_b32 v43, s34, v135
    v_or3_b32 v52, v32, v33, v34
    v_or3_b32 v52, v52, v35, v36
    v_or3_b32 v52, v52, v37, v38
    v_or3_b32 v52, v52, v39, v40
    v_or3_b32 v52, v52, v41, v42
    v_or_b32 v52, v52, v43
    v_and_b32 v52, v8, v52
    v_cmp_ne_u32 vcc, 0, v52
    s_cmp_eq_u64 vcc, 0
    s_cbranch_scc1 L_f_ok
    global_load_dwordx4 v[124:127], v24, s[28:29] offset:0 sc1
    global_load_dwordx4 v[128:131], v24, s[28:29] offset:1024 sc1
    global_load_dwordx4 v[132:135], v24, s[28:29] offset:2048 sc1
    s_waitcnt vmcnt(6)
    v_xor_b32 v32, s34, v136
    v_xor_b32 v33, s34, v137
    v_xor_b32 v34, s34, v138
    v_xor_b32 v35, s34, v139
    v_xor_b32 v36, s34, v140
    v_xor_b32 v37, s34, v141
    v_xor_b32 v38, s34, v142
    v_xor_b32 v39, s34, v143
    v_xor_b32 v40, s34, v144
    v_xor_b32 v41, s34, v145
    v_xor_b32 v42, s34, v146
    v_xor_b32 v43, s34, v147
    v_or3_b32 v52, v32, v33, v34
    v_or3_b32 v52, v52, v35, v36
    v_or3_b32 v52, v52, v37, v38
    v_or3_b32 v52, v52, v39, v40
    v_or3_b32 v52, v52, v41, v42
    v_or_b32 v52, v52, v43
    v_and_b32 v52, v8, v52
    v_cmp_ne_u32 vcc, 0, v52
    s_cmp_eq_u64 vcc, 0
    s_cbranch_scc1 L_f_ok
    global_load_dwordx4 v[136:139], v24, s[28:29] offset:0 sc1
    global_load_dwordx4 v[140:143], v24, s[28:29] offset:1024 sc1
    global_load_dwordx4 v[144:147], v24, s[28:29] offset:2048 sc1
    s_sub_u32 s46, s46, 1
    s_cbranch_scc0 L_f_loop
L_f_ok:
    v_add_f32 v32, v32, v36
    v_add_f32 v33, v33, v37
    v_add_f32 v34, v34, v38
    v_add_f32 v35, v35, v39
    v_add_f32 v32, v32, v40
    v_add_f32 v33, v33, v41
    v_add_f32 v34, v34, v42
    v_add_f32 v35, v35, v43
    s_nop 0
    v_permlane32_swap_b32 v32, v34
    v_permlane32_swap_b32 v33, v35
    v_add_f32 v32, v32, v34
    v_add_f32 v33, v33, v35
    s_nop 1
    v_permlane16_swap_b32 v32, v33
    v_add_f32 v32, v32, v33
    s_mov_b32 s36, 0x00ff00ff
    s_mov_b32 s37, 0x00ff00ff
    v_add_f32_dpp v32, v32, v32 row_ror:8 row_mask:0xf bank_mask:0xf
    v_cvt_pk_bf16_f32 v32, v32, v32
    s_mov_b64 exec, s[36:37]
    global_store_short v26, v32, s[24:25]
    s_cmp_lg_u32 s38, 0
    s_cbranch_scc1 L_exitS
    s_mov_b64 exec, 1
    v_mov_b32 v53, s33
    global_store_dword v60, v53, s[28:29]
L_exitS:
    s_endpgm
L_service:
    s_mul_i32 s51, s30, 205
    s_lshr_b32 s51, s51, 11
    s_mul_i32 s52, s51, 10
    s_sub_u32 s52, s30, s52
    s_mul_i32 s36, s31, 3
    s_add_u32 s51, s51, s36
    s_min_u32 s51, s51, 23
    v_and_b32 v52, 1, v1
    v_mov_b32 v53, 0xffff
    v_lshlrev_b32 v52, 4, v52
    v_lshlrev_b32 v53, v52, v53
    v_lshrrev_b32 v52, 1, v3
    v_cmp_eq_u32 vcc, 0, v52
    s_nop 1
    v_cndmask_b32 v4, 0, v53, vcc
    v_cmp_eq_u32 vcc, 1, v52
    s_nop 1
    v_cndmask_b32 v5, 0, v53, vcc
    v_cmp_eq_u32 vcc, 2, v52
    s_nop 1
    v_cndmask_b32 v6, 0, v53, vcc
    v_cmp_eq_u32 vcc, 3, v52
    s_nop 1
    v_cndmask_b32 v7, 0, v53, vcc
    v_mov_b32 v8, 0xff
    v_mov_b32 v61, 1
    s_mov_b32 s46, 200000
    v_lshlrev_b32 v160, 4, v1
    v_lshlrev_b32 v164, 2, v2
    s_add_u32 s44, s28, 4096
    s_addc_u32 s45, s29, 0
    s_lshl_b32 s36, s3, 10
    s_add_u32 s36, s36, 114688
    s_add_u32 s42, s28, s36
    s_addc_u32 s43, s29, 0
    s_mov_b32 s47, 0x01000100
    s_mov_b32 s48, 0x03020302
    v_and_b32 v55, 1, v2
    v_lshlrev_b32 v55, 4, v55
    v_lshlrev_b32 v56, 5, v3
    v_bfe_u32 v53, v1, 4, 1
    v_lshl_add_u32 v56, v53, 4, v56
    v_lshrrev_b32 v53, 5, v1
    v_lshl_add_u32 v56, v53, 3, v56
    s_lshl_b32 s36, s32, 9
    v_add_u32 v56, s36, v56
    s_mov_b32 s56, 0x00ff00ff
    s_mov_b32 s57, 0x00ff00ff
    s_waitcnt vmcnt(11)
    v_alignbit_b32 v20, v21, v20, v55
    v_alignbit_b32 v21, v22, v21, v55
    v_lshrrev_b32 v22, v55, v22
    s_waitcnt vmcnt(10)
    v_perm_b32 v52, v20, v20, s47
    v_and_b32 v12, v52, v4
    v_and_b32 v13, v52, v5
    v_and_b32 v14, v52, v6
    v_and_b32 v15, v52, v7
    s_nop 1
    v_mfma_f32_16x16x32_bf16 v[40:43], v[12:15], v[64:67], 0
    s_waitcnt vmcnt(9)
    v_perm_b32 v52, v20, v20, s48
    v_and_b32 v16, v52, v4
    v_and_b32 v17, v52, v5
    v_and_b32 v18, v52, v6
    v_and_b32 v19, v52, v7
    s_nop 1
    v_mfma_f32_16x16x32_bf16 v[40:43], v[16:19], v[68:71], v[40:43]
    s_waitcnt vmcnt(8)
    v_perm_b32 v52, v21, v21, s47
    v_and_b32 v12, v52, v4
    v_and_b32 v13, v52, v5
    v_and_b32 v14, v52, v6
    v_and_b32 v15, v52, v7
    s_nop 1
    v_mfma_f32_16x16x32_bf16 v[40:43], v[12:15], v[72:75], v[40:43]
    s_waitcnt vmcnt(7)
    v_perm_b32 v52, v21, v21, s48
    v_and_b32 v16, v52, v4
    v_and_b32 v17, v52, v5
    v_and_b32 v18, v52, v6
    v_and_b32 v19, v52, v7
    s_nop 1
    v_mfma_f32_16x16x32_bf16 v[40:43], v[16:19], v[76:79], v[40:43]
    s_waitcnt vmcnt(6)
    v_perm_b32 v52, v22, v22, s47
    v_and_b32 v12, v52, v4
    v_and_b32 v13, v52, v5
    v_and_b32 v14, v52, v6
    v_and_b32 v15, v52, v7
    s_nop 1
    v_mfma_f32_16x16x32_bf16 v[40:43], v[12:15], v[80:83], v[40:43]
    s_nop 7
    v_permlane32_swap_b32 v40, v42
    v_permlane32_swap_b32 v41, v43
    s_nop 1
    v_add_f32_dpp v44, v42, v40 row_ror:8 row_mask:0xf bank_mask:0xf
    v_add_f32_dpp v45, v43, v41 row_ror:8 row_mask:0xf bank_mask:0xf
    s_mov_b64 exec, s[56:57]
    ds_write_b64 v56, v[44:45] offset:768
    s_mov_b64 exec, -1
    s_waitcnt vmcnt(5)
    v_alignbit_b32 v24, v25, v24, v55
    v_alignbit_b32 v25, v26, v25, v55
    v_lshrrev_b32 v26, v55, v26
    s_waitcnt vmcnt(4)
    v_perm_b32 v52, v24, v24, s47
    v_and_b32 v12, v52, v4
    v_and_b32 v13, v52, v5
    v_and_b32 v14, v52, v6
    v_and_b32 v15, v52, v7
    s_nop 1
    v_mfma_f32_16x16x32_bf16 v[40:43], v[12:15], v[84:87], 0
    s_waitcnt vmcnt(3)
    v_perm_b32 v52, v24, v24, s48
    v_and_b32 v16, v52, v4
    v_and_b32 v17, v52, v5
    v_and_b32 v18, v52, v6
    v_and_b32 v19, v52, v7
    s_nop 1
    v_mfma_f32_16x16x32_bf16 v[40:43], v[16:19], v[88:91], v[40:43]
    s_waitcnt vmcnt(2)
    v_perm_b32 v52, v25, v25, s47
    v_and_b32 v12, v52, v4
    v_and_b32 v13, v52, v5
    v_and_b32 v14, v52, v6
    v_and_b32 v15, v52, v7
    s_nop 1
    v_mfma_f32_16x16x32_bf16 v[40:43], v[12:15], v[92:95], v[40:43]
    s_waitcnt vmcnt(1)
    v_perm_b32 v52, v25, v25, s48
    v_and_b32 v16, v52, v4
    v_and_b32 v17, v52, v5
    v_and_b32 v18, v52, v6
    v_and_b32 v19, v52, v7
    s_nop 1
    v_mfma_f32_16x16x32_bf16 v[40:43], v[16:19], v[96:99], v[40:43]
    s_waitcnt vmcnt(0)
    v_perm_b32 v52, v26, v26, s47
    v_and_b32 v12, v52, v4
    v_and_b32 v13, v52, v5
    v_and_b32 v14, v52, v6
    v_and_b32 v15, v52, v7
    s_nop 1
    v_mfma_f32_16x16x32_bf16 v[40:43], v[12:15], v[100:103], v[40:43]
    s_nop 7
    v_permlane32_swap_b32 v40, v42
    v_permlane32_swap_b32 v41, v43
    s_nop 1
    v_add_f32_dpp v44, v42, v40 row_ror:8 row_mask:0xf bank_mask:0xf
    v_add_f32_dpp v45, v43, v41 row_ror:8 row_mask:0xf bank_mask:0xf
    s_mov_b64 exec, s[56:57]
    ds_write_b64 v56, v[44:45] offset:1024
    s_mov_b64 exec, -1
    s_waitcnt lgkmcnt(0)
    s_add_u32 s33, s33, 1
    s_and_b32 s34, s33, 0xff
    s_cmp_eq_u32 s32, 3
    s_cbranch_scc1 L_publish
    s_mov_b64 exec, 1
    ds_add_u32 v60, v61 offset:400
    s_mov_b64 exec, -1
    s_branch L_jobs
L_publish:
    v_alignbit_b32 v28, v29, v28, v55
    v_alignbit_b32 v29, v30, v29, v55
    v_lshrrev_b32 v30, v55, v30
    v_perm_b32 v52, v28, v28, s47
    v_and_b32 v12, v52, v4
    v_and_b32 v13, v52, v5
    v_and_b32 v14, v52, v6
    v_and_b32 v15, v52, v7
    s_nop 1
    v_mfma_f32_16x16x32_bf16 v[40:43], v[12:15], v[104:107], 0
    v_perm_b32 v52, v28, v28, s48
    v_and_b32 v16, v52, v4
    v_and_b32 v17, v52, v5
    v_and_b32 v18, v52, v6
    v_and_b32 v19, v52, v7
    s_nop 1
    v_mfma_f32_16x16x32_bf16 v[40:43], v[16:19], v[108:111], v[40:43]
    v_perm_b32 v52, v29, v29, s47
    v_and_b32 v12, v52, v4
    v_and_b32 v13, v52, v5
    v_and_b32 v14, v52, v6
    v_and_b32 v15, v52, v7
    s_nop 1
    v_mfma_f32_16x16x32_bf16 v[40:43], v[12:15], v[112:115], v[40:43]
    v_perm_b32 v52, v29, v29, s48
    v_and_b32 v16, v52, v4
    v_and_b32 v17, v52, v5
    v_and_b32 v18, v52, v6
    v_and_b32 v19, v52, v7
    s_nop 1
    v_mfma_f32_16x16x32_bf16 v[40:43], v[16:19], v[116:119], v[40:43]
    v_perm_b32 v52, v30, v30, s47
    v_and_b32 v12, v52, v4
    v_and_b32 v13, v52, v5
    v_and_b32 v14, v52, v6
    v_and_b32 v15, v52, v7
    s_nop 1
    v_mfma_f32_16x16x32_bf16 v[40:43], v[12:15], v[120:123], v[40:43]
    s_nop 7
    v_permlane32_swap_b32 v40, v42
    v_permlane32_swap_b32 v41, v43
    s_nop 1
    v_add_f32_dpp v44, v42, v40 row_ror:8 row_mask:0xf bank_mask:0xf
    v_add_f32_dpp v45, v43, v41 row_ror:8 row_mask:0xf bank_mask:0xf
    s_mov_b64 exec, s[56:57]
    ds_write_b64 v56, v[44:45] offset:1280
    s_mov_b64 exec, -1
    v_lshlrev_b32 v52, 2, v1
    v_add_u32 v53, 768, v52
L_pwait:
    ds_read_b32 v54, v60 offset:400
    s_waitcnt lgkmcnt(0)
    v_cmp_ne_u32 vcc, 3, v54
    s_cmp_eq_u64 vcc, 0
    s_cbranch_scc1 L_pwait_ok
    s_sleep 1
    s_branch L_pwait
L_pwait_ok:
    ds_read2st64_b32 v[40:41], v53 offset0:0 offset1:1
    ds_read2st64_b32 v[42:43], v53 offset0:2 offset1:3
    ds_read2st64_b32 v[44:45], v53 offset0:4 offset1:5
    ds_read2st64_b32 v[46:47], v53 offset0:6 offset1:7
    ds_read_b32 v48, v53 offset:2048
    s_lshr_b32 s37, s58, 4
    s_and_b32 s36, s58, 15
    s_sub_u32 s38, 16, s36
    s_mul_i32 s39, s37, 1821
    s_lshr_b32 s39, s39, 10
    s_sub_u32 s39, s30, s39
    s_mul_i32 s40, s31, 12
    s_mul_i32 s36, s31, 6
    s_add_u32 s36, s36, 84
    s_cmp_lt_u32 s37, 12
    s_cselect_b32 s40, s40, s36
    s_add_u32 s40, s40, s37
    s_mul_i32 s40, s40, 768
    s_lshl_b32 s39, s39, 8
    s_add_u32 s40, s40, s39
    s_add_u32 s37, s37, 1
    s_mul_i32 s41, s31, 12
    s_mul_i32 s36, s31, 6
    s_add_u32 s36, s36, 84
    s_cmp_lt_u32 s37, 12
    s_cselect_b32 s41, s41, s36
    s_add_u32 s41, s41, s37
    s_mul_i32 s41, s41, 768
    v_add_u32 v53, s41, v52
    v_add_u32 v52, s40, v52
    v_mov_b32 v50, 0
    s_waitcnt lgkmcnt(0)
    s_cmp_gt_u32 s38, 1
    s_cbranch_scc0 L_pb1
    v_add_f32 v40, v40, v41
    s_cmp_gt_u32 s38, 2
    s_cbranch_scc0 L_pb2
    v_add_f32 v40, v40, v42
    s_cmp_gt_u32 s38, 3
    s_cbranch_scc0 L_pb3
    v_add_f32 v40, v40, v43
    s_cmp_gt_u32 s38, 4
    s_cbranch_scc0 L_pb4
    v_add_f32 v40, v40, v44
    s_cmp_gt_u32 s38, 5
    s_cbranch_scc0 L_pb5
    v_add_f32 v40, v40, v45
    s_cmp_gt_u32 s38, 6
    s_cbranch_scc0 L_pb6
    v_add_f32 v40, v40, v46
    s_cmp_gt_u32 s38, 7
    s_cbranch_scc0 L_pb7
    v_add_f32 v40, v40, v47
    s_cmp_gt_u32 s38, 8
    s_cbranch_scc0 L_pb8
    v_add_f32 v40, v40, v48
    s_branch L_pb9
L_pb1:
    v_add_f32 v50, v50, v41
L_pb2:
    v_add_f32 v50, v50, v42
L_pb3:
    v_add_f32 v50, v50, v43
L_pb4:
    v_add_f32 v50, v50, v44
L_pb5:
    v_add_f32 v50, v50, v45
L_pb6:
    v_add_f32 v50, v50, v46
L_pb7:
    v_add_f32 v50, v50, v47
L_pb8:
    v_add_f32 v50, v50, v48
    v_bfi_b32 v50, v8, s34, v50
    global_store_dword v53, v50, s[44:45] sc1
L_pb9:
    v_bfi_b32 v40, v8, s34, v40
    global_store_dword v52, v40, s[44:45] sc1
L_jobs:
    s_cmp_eq_u32 s32, 1
    s_cbranch_scc1 L_jobH
    s_cmp_eq_u32 s32, 2
    s_cbranch_scc1 L_jobG
    s_cmp_eq_u32 s32, 3
    s_cbranch_scc1 L_jobF
L_jobQ:
    v_min_u32 v54, 47, v1
    v_lshrrev_b32 v53, 4, v54
    v_and_b32 v52, 15, v54
    s_mul_i32 s36, s3, 2304
    v_mul_u32_u24 v30, 768, v53
    v_lshl_add_u32 v30, v52, 4, v30
    v_add_u32 v30, s36, v30
    s_and_b32 s36, s3, 3
    s_mul_i32 s36, s36, 3
    s_lshr_b32 s36, 0x22311, s36
    v_lshrrev_b32 v53, v53, s36
    v_and_b32 v53, 1, v53
    v_cmp_eq_u32 s[56:57], 0, v53
    v_xor_b32 v53, 1, v53
    v_lshl_add_u32 v31, v53, 9, v30
    v_lshlrev_b32 v57, 3, v54
    global_load_dwordx4 v[128:131], v30, s[44:45] sc1
    global_load_dwordx4 v[132:135], v30, s[44:45] offset:256 sc1
    global_load_dwordx4 v[136:139], v31, s[44:45] sc1
    s_waitcnt vmcnt(0)
L_q_chk:
    v_xor_b32 v128, s34, v128
    v_xor_b32 v129, s34, v129
    v_xor_b32 v130, s34, v130
    v_xor_b32 v131, s34, v131
    v_xor_b32 v132, s34, v132
    v_xor_b32 v133, s34, v133
    v_xor_b32 v134, s34, v134
    v_xor_b32 v135, s34, v135
    v_xor_b32 v136, s34, v136
    v_xor_b32 v137, s34, v137
    v_xor_b32 v138, s34, v138
    v_xor_b32 v139, s34, v139
    v_or3_b32 v52, v128, v129, v130
    v_or3_b32 v52, v52, v131, v132
    v_or3_b32 v52, v52, v133, v134
    v_or3_b32 v52, v52, v135, v136
    v_or3_b32 v52, v52, v137, v138
    v_or_b32 v52, v52, v139
    v_and_b32 v52, v8, v52
    v_cmp_ne_u32 vcc, 0, v52
    s_cmp_eq_u64 vcc, 0
    s_cbranch_scc1 L_q_ok
    s_sub_u32 s46, s46, 1
    s_cbranch_scc1 L_q_ok
    s_sleep 8
    global_load_dwordx4 v[128:131], v30, s[44:45] sc1
    global_load_dwordx4 v[132:135], v30, s[44:45] offset:256 sc1
    global_load_dwordx4 v[136:139], v31, s[44:45] sc1
    s_waitcnt vmcnt(0)
    s_branch L_q_chk
L_q_ok:
    v_cndmask_b32 v136, 0, v136, s[56:57]
    v_cndmask_b32 v137, 0, v137, s[56:57]
    v_cndmask_b32 v138, 0, v138, s[56:57]
    v_cndmask_b32 v139, 0, v139, s[56:57]
    v_add_f32 v128, v128, v132
    v_add_f32 v129, v129, v133
    v_add_f32 v130, v130, v134
    v_add_f32 v131, v131, v135
    v_add_f32 v128, v128, v136
    v_add_f32 v129, v129, v137
    v_add_f32 v130, v130, v138
    v_add_f32 v131, v131, v139
    v_cvt_pk_bf16_f32 v52, v128, v129
    v_cvt_pk_bf16_f32 v53, v130, v131
    ds_write_b64 v57, v[52:53] offset:0
    ds_write_b32 v60, v61 offset:392
    s_branch L_svc_done
L_jobH:
    v_lshlrev_b32 v57, 2, v1
    s_mul_i32 s36, s51, 768
    s_add_u32 s36, s36, 73728
    v_add_u32 v30, s36, v57
    v_add_u32 v31, 18432, v30
    s_mul_i32 s36, s51, 43
    s_lshr_b32 s36, s36, 8
    s_mul_i32 s36, s36, 6
    s_sub_u32 s36, s51, s36
    s_add_u32 s36, s36, 12
    s_lshr_b32 s36, 0x22311, s36
    s_and_b32 s36, s36, 1
    s_cmp_eq_u32 s36, 0
    s_cselect_b32 s59, 1.0, 0
    s_cselect_b32 s36, 512, 0
    v_add_u32 v28, s36, v30
    v_add_u32 v29, s36, v31
    v_lshlrev_b32 v27, 3, v3
L_hwait:
    ds_read_b32 v54, v60 offset:396
    s_waitcnt lgkmcnt(0)
    v_cmp_eq_u32 vcc, 0, v54
    s_cmp_eq_u64 vcc, 0
    s_cbranch_scc1 L_hwait_ok
    s_sleep 16
    s_branch L_hwait
L_hwait_ok:
    global_load_dword v128, v30, s[44:45] sc1
    global_load_dword v129, v31, s[44:45] sc1
    global_load_dword v130, v30, s[44:45] offset:256 sc1
    global_load_dword v131, v31, s[44:45] offset:256 sc1
    global_load_dword v132, v28, s[44:45] sc1
    global_load_dword v133, v29, s[44:45] sc1
    global_load_dwordx2 v[134:135], v27, s[28:29] offset:1024 sc1
    s_waitcnt vmcnt(0)
L_h_chk:
    v_xor_b32 v128, s34, v128
    v_xor_b32 v129, s34, v129
    v_xor_b32 v130, s34, v130
    v_xor_b32 v131, s34, v131
    v_xor_b32 v132, s34, v132
    v_xor_b32 v133, s34, v133
    v_xor_b32 v134, s34, v134
    v_xor_b32 v135, s34, v135
    v_or3_b32 v52, v128, v129, v130
    v_or3_b32 v52, v52, v131, v132
    v_or3_b32 v52, v52, v133, v134
    v_or_b32 v52, v52, v135
    v_and_b32 v52, v8, v52
    v_cmp_ne_u32 vcc, 0, v52
    s_cmp_eq_u64 vcc, 0
    s_cbranch_scc1 L_h_ok
    s_sub_u32 s46, s46, 1
    s_cbranch_scc1 L_h_ok
    s_sleep 16
    global_load_dword v128, v30, s[44:45] sc1
    global_load_dword v129, v31, s[44:45] sc1
    global_load_dword v130, v30, s[44:45] offset:256 sc1
    global_load_dword v131, v31, s[44:45] offset:256 sc1
    global_load_dword v132, v28, s[44:45] sc1
    global_load_dword v133, v29, s[44:45] sc1
    global_load_dwordx2 v[134:135], v27, s[28:29] offset:1024 sc1
    s_waitcnt vmcnt(0)
    s_branch L_h_chk
L_h_ok:
    ds_write_b64 v60, v[134:135] offset:384
    v_add_f32 v128, v128, v130
    v_add_f32 v129, v129, v131
    v_fma_f32 v128, v132, s59, v128
    v_fma_f32 v129, v133, s59, v129
    v_cvt_pk_bf16_f32 v52, v128, v128
    v_and_b32 v52, 0xffff0000, v52
    v_cvt_pk_bf16_f32 v53, v129, v129
    v_and_b32 v53, 0xffff0000, v53
    v_mul_f32 v54, v52, v52
    v_mov_b32 v55, 0x3d372713
    v_fma_f32 v54, v54, v55, 1.0
    v_mul_f32 v54, v54, v52
    v_mul_f32 v54, 0xc0135761, v54
    v_exp_f32 v54, v54
    s_nop 0
    v_add_f32 v54, 1.0, v54
    v_rcp_f32 v54, v54
    s_nop 0
    v_mul_f32 v54, v54, v52
    v_cvt_pk_bf16_f32 v54, v54, v54
    v_and_b32 v54, 0xffff0000, v54
    v_mul_f32 v54, v54, v53
    v_cvt_pk_bf16_f32 v54, v54, v54
    ds_write_b32 v57, v54 offset:512
    s_branch L_svc_done
L_jobG:
    s_cmp_lg_u32 s2, 255
    s_cbranch_scc1 L_svc_done
    v_mul_u32_u24 v53, 20, v1
    global_load_dwordx4 v[128:131], v53, s[4:5]
    global_load_dword v132, v53, s[4:5] offset:16
    global_load_dwordx4 v[134:137], v53, s[22:23]
    global_load_dword v138, v53, s[22:23] offset:16
    v_mov_b32 v56, 0
    s_waitcnt vmcnt(0)
    v_lshlrev_b32 v52, 16, v128
    v_and_b32 v53, 0xffff0000, v128
    v_lshlrev_b32 v54, 16, v134
    v_and_b32 v55, 0xffff0000, v134
    v_mul_f32 v52, v52, v54
    v_mul_f32 v53, v53, v55
    v_cvt_pk_bf16_f32 v52, v52, v53
    v_lshlrev_b32 v53, 16, v52
    v_and_b32 v52, 0xffff0000, v52
    v_add_f32 v56, v56, v53
    v_add_f32 v56, v56, v52
    v_lshlrev_b32 v52, 16, v129
    v_and_b32 v53, 0xffff0000, v129
    v_lshlrev_b32 v54, 16, v135
    v_and_b32 v55, 0xffff0000, v135
    v_mul_f32 v52, v52, v54
    v_mul_f32 v53, v53, v55
    v_cvt_pk_bf16_f32 v52, v52, v53
    v_lshlrev_b32 v53, 16, v52
    v_and_b32 v52, 0xffff0000, v52
    v_add_f32 v56, v56, v53
    v_add_f32 v56, v56, v52
    v_lshlrev_b32 v52, 16, v130
    v_and_b32 v53, 0xffff0000, v130
    v_lshlrev_b32 v54, 16, v136
    v_and_b32 v55, 0xffff0000, v136
    v_mul_f32 v52, v52, v54
    v_mul_f32 v53, v53, v55
    v_cvt_pk_bf16_f32 v52, v52, v53
    v_lshlrev_b32 v53, 16, v52
    v_and_b32 v52, 0xffff0000, v52
    v_add_f32 v56, v56, v53
    v_add_f32 v56, v56, v52
    v_lshlrev_b32 v52, 16, v131
    v_and_b32 v53, 0xffff0000, v131
    v_lshlrev_b32 v54, 16, v137
    v_and_b32 v55, 0xffff0000, v137
    v_mul_f32 v52, v52, v54
    v_mul_f32 v53, v53, v55
    v_cvt_pk_bf16_f32 v52, v52, v53
    v_lshlrev_b32 v53, 16, v52
    v_and_b32 v52, 0xffff0000, v52
    v_add_f32 v56, v56, v53
    v_add_f32 v56, v56, v52
    v_lshlrev_b32 v52, 16, v132
    v_and_b32 v53, 0xffff0000, v132
    v_lshlrev_b32 v54, 16, v138
    v_and_b32 v55, 0xffff0000, v138
    v_mul_f32 v52, v52, v54
    v_mul_f32 v53, v53, v55
    v_cvt_pk_bf16_f32 v52, v52, v53
    v_lshlrev_b32 v53, 16, v52
    v_and_b32 v52, 0xffff0000, v52
    v_add_f32 v56, v56, v53
    v_add_f32 v56, v56, v52
    s_nop 1
    v_add_f32_dpp v56, v56, v56 quad_perm:[1,0,3,2] row_mask:0xf bank_mask:0xf
    s_nop 1
    v_add_f32_dpp v56, v56, v56 quad_perm:[2,3,0,1] row_mask:0xf bank_mask:0xf
    s_nop 1
    v_add_f32_dpp v56, v56, v56 row_half_mirror row_mask:0xf bank_mask:0xf
    s_nop 1
    v_add_f32_dpp v56, v56, v56 row_mirror row_mask:0xf bank_mask:0xf
    s_nop 1
    v_add_f32_dpp v56, v56, v56 row_bcast:15 row_mask:0xa bank_mask:0xf
    s_nop 1
    v_add_f32_dpp v56, v56, v56 row_bcast:31 row_mask:0xc bank_mask:0xf
    s_nop 0
    v_readlane_b32 s36, v56, 63
    s_nop 1
    v_mov_b32 v56, s36
    v_cvt_pk_bf16_f32 v56, v56, v56
    v_and_b32 v56, 0xffff0000, v56
    v_mul_f32 v56, 0xbfb8aa3b, v56
    v_exp_f32 v56, v56
    s_nop 0
    v_add_f32 v56, 1.0, v56
    v_rcp_f32 v56, v56
    s_nop 0
    v_cvt_pk_bf16_f32 v56, v56, v56
    v_and_b32 v56, 0xffff0000, v56
    v_sub_f32 v57, 1.0, v56
    v_cvt_pk_bf16_f32 v57, v57, v57
    v_and_b32 v57, 0xffff0000, v57
    v_bfi_b32 v56, v8, s34, v56
    v_bfi_b32 v57, v8, s34, v57
    v_lshlrev_b32 v52, 3, v1
    s_mov_b64 exec, 0xff
    global_store_dwordx2 v52, v[56:57], s[28:29] offset:1024 sc1
    s_mov_b64 exec, -1
    s_branch L_svc_done
L_jobF:
    v_lshlrev_b32 v55, 2, v3
L_fwait:
    ds_read_b32 v54, v60 offset:396
    s_waitcnt lgkmcnt(0)
    v_cmp_ne_u32 vcc, 8, v54
    s_cmp_eq_u64 vcc, 0
    s_cbranch_scc1 L_fwait_ok
    s_sleep 8
    s_branch L_fwait
L_fwait_ok:
    ds_read2_b32 v[56:57], v55 offset0:112 offset1:120
    v_mov_b32 v58, s33
    v_mov_b32 v59, s33
    s_lshl_b32 s36, s60, 7
    v_add_u32 v52, s36, v160
    s_waitcnt lgkmcnt(0)
    s_mov_b64 exec, 0xff
    global_store_dwordx4 v52, v[56:59], s[42:43] sc1
    s_mov_b64 exec, -1
    s_waitcnt vmcnt(0)
    global_load_dwordx4 v[128:131], v160, s[42:43] sc1
    s_waitcnt vmcnt(0)
L_hd_chk:
    v_xor_b32 v52, s33, v130
    v_xor_b32 v53, s33, v131
    v_or_b32 v52, v52, v53
    v_cmp_ne_u32 vcc, 0, v52
    s_cmp_eq_u64 vcc, 0
    s_cbranch_scc1 L_hd_ok
    s_sub_u32 s46, s46, 1
    s_cbranch_scc1 L_hd_ok
    s_sleep 8
    global_load_dwordx4 v[128:131], v160, s[42:43] sc1
    s_waitcnt vmcnt(0)
    s_branch L_hd_chk
L_hd_ok:
    v_mov_b32 v52, v128
    s_nop 1
    v_max_f32_dpp v52, v52, v52 quad_perm:[1,0,3,2] row_mask:0xf bank_mask:0xf
    s_nop 1
    v_max_f32_dpp v52, v52, v52 quad_perm:[2,3,0,1] row_mask:0xf bank_mask:0xf
    s_nop 1
    v_max_f32_dpp v52, v52, v52 row_half_mirror row_mask:0xf bank_mask:0xf
    s_nop 1
    v_max_f32_dpp v52, v52, v52 row_mirror row_mask:0xf bank_mask:0xf
    s_nop 1
    v_max_f32_dpp v52, v52, v52 row_bcast:15 row_mask:0xa bank_mask:0xf
    s_nop 1
    v_max_f32_dpp v52, v52, v52 row_bcast:31 row_mask:0xc bank_mask:0xf
    s_nop 0
    v_readlane_b32 s36, v52, 63
    s_nop 1
    v_subrev_f32 v52, s36, v128
    v_exp_f32 v52, v52
    s_nop 0
    v_mul_f32 v53, v52, v129
    s_nop 1
    v_add_f32_dpp v53, v53, v53 quad_perm:[1,0,3,2] row_mask:0xf bank_mask:0xf
    s_nop 1
    v_add_f32_dpp v53, v53, v53 quad_perm:[2,3,0,1] row_mask:0xf bank_mask:0xf
    s_nop 1
    v_add_f32_dpp v53, v53, v53 row_half_mirror row_mask:0xf bank_mask:0xf
    s_nop 1
    v_add_f32_dpp v53, v53, v53 row_mirror row_mask:0xf bank_mask:0xf
    s_nop 1
    v_add_f32_dpp v53, v53, v53 row_bcast:15 row_mask:0xa bank_mask:0xf
    s_nop 1
    v_add_f32_dpp v53, v53, v53 row_bcast:31 row_mask:0xc bank_mask:0xf
    v_rcp_f32 v53, v53
    s_nop 0
    v_readlane_b32 s36, v53, 63
    v_cmp_eq_u32 vcc, s60, v2
    s_nop 0
    v_mul_f32 v52, s36, v52
    s_mov_b64 exec, vcc
    ds_write_b32 v55, v52 offset:416
    s_mov_b64 exec, -1
L_svc_done:
    s_waitcnt lgkmcnt(0)
    s_barrier
L_exit:
L_end:
    s_endpgm
.section .rodata,"a"
.p2align 6
.amdhsa_kernel gated_mix__sliding_block_cached__geglu_ffn__decode_kernel
  .amdhsa_next_free_vgpr 168
  .amdhsa_next_free_sgpr 96
  .amdhsa_accum_offset 168
  .amdhsa_group_segment_fixed_size 0
  .amdhsa_kernarg_size 104
  .amdhsa_user_sgpr_count 2
  .amdhsa_user_sgpr_kernarg_segment_ptr 1
  .amdhsa_system_sgpr_workgroup_id_x 1
  .amdhsa_float_denorm_mode_32 3
.end_amdhsa_kernel
```
